```python
import torch

def _softmax(x, axis=-1):
    return torch.softmax(x, dim=axis)
def _gelu(x):
    return torch.nn.functional.gelu(x, approximate="tanh")
def _silu(x):
    return torch.nn.functional.silu(x)
def _sigmoid(x):
    return torch.sigmoid(x)
def _layernorm(x, axis=-1, eps=1e-5):
    m = x.mean(dim=axis, keepdim=True)
    v = x.var(dim=axis, keepdim=True, unbiased=False)
    return (x - m) / torch.sqrt(v + eps)
def _scatter_add(tgt, idx, src, axis=0):
    return tgt.clone().index_add_(axis, idx, src)
def _segment_sum(src, seg, n):
    out = torch.zeros((n,) + src.shape[1:], dtype=src.dtype)
    return out.index_add_(0, seg, src)
def _pad(x, pw):
    flat = tuple(v for pair in reversed(pw) for v in pair)
    return torch.nn.functional.pad(x, flat)

kernel_name = 'standalone__sliding_block_cached__sampling'

def setup_inputs():

    _w = (lambda a: (lambda t: t.to(torch.bfloat16) if t.is_floating_point() else t)(torch.as_tensor(a)))
    B, Sq, D = 16, 1, 512
    Hq, Hkv, Sk, Dh = 32, 8, 4096, 128
    assert Hq % Hkv == 0, (Hq, Hkv)
    return {
        "x": _w((lambda *s: torch.randn(*s, dtype=torch.bfloat16) * 0.8)(B, Sq, D)),
        "k_cache": _w((lambda *s: torch.randn(*s, dtype=torch.bfloat16) * 0.8)(B, Hkv, Sk, Dh)),
        "v_cache": _w((lambda *s: torch.randn(*s, dtype=torch.bfloat16) * 0.05)(B, Hkv, Sk, Dh)),
        "wq": _w((lambda *s: torch.randn(*s, dtype=torch.bfloat16) * 0.8)(D, Hq * Dh) * (D ** -0.5)),
        "wo": _w((lambda *s: torch.randn(*s, dtype=torch.bfloat16) * 0.05)(Hq * Dh, D) * ((Hq * Dh) ** -0.5)),
    }

def reference(x, k_cache, v_cache, wq, wo):
    B, Sq, D = x.shape
    Hq, Dh = 32, 128
    Hkv, Sk = k_cache.shape[1], k_cache.shape[2]
    W = min(4096, max(256, Sk // 4))
    rep = Hq // Hkv
    q = (lambda x, *d: x.permute(*d))((x @ wq).reshape(B, Sq, Hq, Dh), 0, 2, 1, 3)
    k = (lambda x, n, axis: torch.repeat_interleave(x, n, dim=axis))(k_cache[:, :, Sk - W:, :], rep, axis=1)
    v = (lambda x, n, axis: torch.repeat_interleave(x, n, dim=axis))(v_cache[:, :, Sk - W:, :], rep, axis=1)
    scores = torch.einsum("bhqd,bhkd->bhqk", q, k) * (Dh ** -0.5)
    p = _softmax(scores, axis=-1)
    o = torch.einsum("bhqk,bhkd->bhqd", p, v)
    return (lambda x, *d: x.permute(*d))(o, 0, 2, 1, 3).reshape(B, Sq, Hq * Dh) @ wo
```

```asm
; @launch grid=(256,1,1) block=(256,1,1) lds=38400
.amdgcn_target "amdgcn-amd-amdhsa--gfx950"
.text
.p2align 12
.fill 832, 4, 0xbf810000
.globl standalone__sliding_block_cached__sampling_kernel
.p2align 8
.type standalone__sliding_block_cached__sampling_kernel,@function
standalone__sliding_block_cached__sampling_kernel:
    s_load_dwordx16 s[4:19], s[0:1], 0
    s_cmp_ge_u32 s2, 0x100
    s_cbranch_scc1 L_end
    s_getpc_b64 s[30:31]
    v_lshlrev_b32 v2, 5, v0
    global_load_dword v2, v2, s[30:31] offset:512
    v_lshrrev_b32 v1, 6, v0
    v_and_b32 v0, 63, v0
    v_readfirstlane_b32 s3, v1
    s_and_b32 s20, s2, 7
    s_lshr_b32 s21, s2, 3
    s_lshl_b32 s22, s20, 5
    s_add_u32 s22, s22, s21
    s_movk_i32 s39, 0x4000
    s_movk_i32 s26, 0x1e00
    v_lshlrev_b32 v7, 4, v0
    v_lshrrev_b32 v8, 4, v0
    v_and_b32 v15, 15, v0
    s_and_b32 s48, s21, 3
    s_lshl_b32 s23, s48, 2
    s_add_u32 s23, s23, s3
    s_lshl_b32 s23, s23, 18
    s_and_b32 s24, s22, 0xfc
    s_lshl_b32 s24, s24, 5
    s_add_u32 s23, s23, s24
    v_lshrrev_b32 v3, 3, v0
    v_and_b32 v4, 16, v0
    v_lshlrev_b32 v4, 1, v4
    v_and_b32 v1, 0x70, v7
    v_xor_b32 v4, v4, v1
    v_lshl_add_u32 v1, v3, 13, v4
    v_add_u32 v1, s23, v1
    v_lshl_add_u32 v72, v3, 10, v4
    v_lshl_add_u32 v3, s3, 2, v8
    v_xor_b32 v4, v3, v15
    v_lshlrev_b32 v4, 4, v4
    v_lshl_add_u32 v3, v3, 10, v4
    v_lshl_add_u32 v3, s48, 8, v3
    s_lshl_b32 s24, s3, 12
    s_mov_b32 m0, s24
    s_lshr_b32 s23, s21, 1
    s_lshl_b32 s23, s23, 23
    s_lshl_b32 s25, s3, 10
    s_add_u32 s23, s23, s25
    s_lshl_b32 s24, s20, 20
    s_add_u32 s23, s23, s24
    s_and_b32 s27, s21, 1
    s_lshl_b32 s24, s27, 17
    s_add_u32 s23, s23, s24
    s_add_u32 s23, s23, 0xc1000
    v_add_u32 v6, s23, v7
    v_bfe_u32 v13, v0, 2, 2
    v_and_b32 v14, 48, v7
    v_lshl_add_u32 v14, v8, 6, v14
    v_lshl_add_u32 v14, v13, 8, v14
    v_add_u32 v5, s23, v14
    v_bfe_u32 v4, v0, 5, 1
    v_mad_u32_u24 v6, v4, s26, v6
    v_bfe_u32 v4, v0, 3, 1
    v_mad_u32_u24 v5, v4, s26, v5
    s_add_u32 s25, s25, 0x8000
    s_getreg_b32 s50, hwreg(HW_REG_XCC_ID, 0, 4)
    s_add_u32 s50, s50, 1
    v_mov_b32 v64, s22
    v_mov_b32 v65, s50
    s_mul_i32 s50, s50, 0x01010101
    s_lshl_b32 s54, s21, 16
    s_lshl_b32 s24, s20, 7
    s_add_u32 s54, s54, s24
    s_lshl_b32 s24, s27, 13
    s_add_u32 s54, s54, s24
    s_bfe_u32 s24, s21, 0x30001
    s_lshl_b32 s24, s24, 10
    s_add_u32 s54, s54, s24
    s_lshr_b32 s24, s21, 4
    s_lshl_b32 s24, s24, 14
    s_add_u32 s54, s54, s24
    s_add_u32 s54, s54, 0x200000
    s_xor_b32 s55, s54, 0x2000
    s_waitcnt lgkmcnt(0)
    s_cmp_eq_u32 s3, 1
    s_cbranch_scc1 L_race
    s_cmp_lg_u32 s3, 0
    s_cbranch_scc1 L_first
    s_mov_b64 exec, 1
    global_store_byte v64, v65, s[16:17]
    s_mov_b64 exec, -1
    s_branch L_first
L_race:
    s_load_dword s52, s[18:19], s54
    s_load_dword s53, s[18:19], s55
L_first:
    global_load_lds_dwordx4 v1, s[10:11] offset:0 nt
    v_add_u32 v1, 0xfc00, v1
    v_xor_b32 v1, 64, v1
    global_load_lds_dwordx4 v1, s[10:11] offset:1024 nt
    v_add_u32 v1, 0xfc00, v1
    v_xor_b32 v1, 64, v1
    global_load_lds_dwordx4 v1, s[10:11] offset:2048 nt
    v_add_u32 v1, 0xfc00, v1
    v_xor_b32 v1, 64, v1
    global_load_lds_dwordx4 v1, s[10:11] offset:3072 nt
    s_mov_b32 m0, s25
    s_mov_b32 s51, s50
    global_load_lds_dwordx4 v3, s[4:5]
    s_cmp_lg_u32 s3, 1
    s_cbranch_scc1 L_novote
    s_waitcnt lgkmcnt(1)
    s_getreg_b32 s56, hwreg(HW_REG_IB_STS, 8, 1)
L_novote:
    global_load_dwordx4 v[128:131], v5, s[6:7] offset:-4096 nt
    global_load_dwordx4 v[132:135], v5, s[6:7] offset:0 nt
    global_load_dwordx4 v[136:139], v5, s[6:7] offset:-3584 nt
    global_load_dwordx4 v[140:143], v5, s[6:7] offset:512 nt
    v_add_u32 v5, s39, v5
    v_bfe_u32 v1, v0, 3, 2
    v_xor_b32 v1, s3, v1
    v_lshlrev_b32 v12, 5, v1
    v_lshl_add_u32 v12, v13, 7, v12
    v_lshl_add_u32 v12, v8, 10, v12
    v_and_b32 v1, 3, v0
    v_lshl_add_u32 v12, v1, 3, v12
    v_xor_b32 v1, v15, v8
    v_lshlrev_b32 v1, 4, v1
    v_lshl_add_u32 v76, v15, 8, v1
    v_xor_b32 v77, 64, v76
    v_xor_b32 v78, 128, v76
    v_xor_b32 v79, 192, v76
    s_lshl_b32 s23, s22, 12
    s_add_u32 s23, s23, 0x80000
    s_lshl_b32 s24, s3, 6
    v_lshl_add_u32 v73, v15, 8, s24
    v_lshl_add_u32 v73, v8, 4, v73
    v_lshl_add_u32 v74, s3, 10, v7
    v_add_u32 v4, s23, v74
    global_load_dwordx4 v[144:147], v5, s[6:7] offset:-4096 nt
    global_load_dwordx4 v[148:151], v5, s[6:7] offset:0 nt
    global_load_dwordx4 v[152:155], v5, s[6:7] offset:-3584 nt
    global_load_dwordx4 v[156:159], v5, s[6:7] offset:512 nt
    v_add_u32 v5, s39, v5
    s_waitcnt lgkmcnt(0)
    s_waitcnt vmcnt(8)
    s_barrier
    ds_read_b64_tr_b16 v[112:113], v12 offset:0
    ds_read_b64_tr_b16 v[114:115], v12 offset:512
    ds_read_b128 v[96:99], v76 offset:32768
    ds_read_b64_tr_b16 v[116:117], v12 offset:4096
    ds_read_b64_tr_b16 v[118:119], v12 offset:4608
    ds_read_b128 v[100:103], v77 offset:32768
    ds_read_b64_tr_b16 v[120:121], v12 offset:8192
    ds_read_b64_tr_b16 v[122:123], v12 offset:8704
    ds_read_b128 v[104:107], v78 offset:32768
    ds_read_b64_tr_b16 v[124:125], v12 offset:12288
    ds_read_b64_tr_b16 v[126:127], v12 offset:12800
    ds_read_b128 v[108:111], v79 offset:32768
    global_load_dwordx4 v[160:163], v5, s[6:7] offset:-4096 nt
    s_waitcnt lgkmcnt(9)
    v_mfma_f32_16x16x32_bf16 v[32:35], v[112:115], v[96:99], 0
    s_waitcnt lgkmcnt(6)
    v_mfma_f32_16x16x32_bf16 v[32:35], v[116:119], v[100:103], v[32:35]
    s_waitcnt lgkmcnt(3)
    v_mfma_f32_16x16x32_bf16 v[32:35], v[120:123], v[104:107], v[32:35]
    s_waitcnt lgkmcnt(0)
    v_mfma_f32_16x16x32_bf16 v[32:35], v[124:127], v[108:111], v[32:35]
    s_lshl_b32 s25, s20, 5
    s_load_dwordx8 s[40:47], s[16:17], s25
    s_load_dwordx2 s[28:29], s[18:19], 0x0
    global_load_dwordx4 v[164:167], v5, s[6:7] offset:0 nt
    global_load_dwordx4 v[168:171], v5, s[6:7] offset:-3584 nt
    global_load_dwordx4 v[172:175], v5, s[6:7] offset:512 nt
    v_add_u32 v5, s39, v5
    s_waitcnt vmcnt(11)
    global_load_dwordx4 v[176:179], v5, s[6:7] offset:-4096 nt
    s_waitcnt vmcnt(11)
    global_load_dwordx4 v[180:183], v5, s[6:7] offset:0 nt
    s_waitcnt vmcnt(11)
    global_load_dwordx4 v[184:187], v5, s[6:7] offset:-3584 nt
    s_lshl_b32 s23, s20, 17
    s_lshl_b32 s24, s3, 15
    s_add_u32 s23, s23, s24
    s_lshr_b32 s24, s21, 1
    s_lshl_b32 s24, s24, 8
    s_add_u32 s23, s23, s24
    s_add_u32 s23, s23, 0x80000
    v_lshl_add_u32 v68, v8, 12, s23
    v_lshl_add_u32 v68, v15, 4, v68
    v_add_u32 v69, 0x4000, v68
    v_mov_b32 v105, 0xfffffc00
    v_add_u32 v32, 0x200, v32
    v_add_u32 v33, 0x200, v33
    v_add_u32 v34, 0x200, v34
    v_add_u32 v35, 0x200, v35
    ds_write_b128 v73, v[32:35] offset:16384
    s_waitcnt lgkmcnt(0)
    s_barrier
    ds_read_b128 v[32:35], v74 offset:16384
    s_mul_i32 s28, s28, 1664525
    s_mul_i32 s29, s29, 1664525
    s_add_u32 s28, s28, 1013904223
    s_add_u32 s29, s29, 1013904223
    s_and_b32 s32, s28, 0x3ff
    s_bfe_u32 s33, s28, 0xa000a
    s_bfe_u32 s34, s28, 0xa0014
    s_and_b32 s35, s29, 0x3ff
    s_xor_b64 s[40:41], s[40:41], s[50:51]
    s_xor_b64 s[42:43], s[42:43], s[50:51]
    s_or_b64 s[40:41], s[40:41], s[42:43]
    s_xor_b64 s[44:45], s[44:45], s[50:51]
    s_or_b64 s[40:41], s[40:41], s[44:45]
    s_xor_b64 s[46:47], s[46:47], s[50:51]
    s_or_b64 s[40:41], s[40:41], s[46:47]
    s_or_b32 s49, s40, s41
    s_waitcnt lgkmcnt(0)
    v_and_or_b32 v32, v32, v105, s32
    v_and_or_b32 v33, v33, v105, s33
    v_and_or_b32 v34, v34, v105, s34
    v_and_or_b32 v35, v35, v105, s35
    s_cmp_lg_u32 s49, 0
    s_cbranch_scc1 L_far0
    global_store_dwordx4 v4, v[32:35], s[18:19]
L_back0:
    s_lshl_b32 s52, s28, 1
    s_lshl_b32 s23, s20, 7
    s_add_u32 s23, s23, 0x4000
    v_and_b32 v1, 31, v0
    v_lshl_add_u32 v70, v1, 2, s23
    s_cmp_lg_u32 s3, 1
    s_cbranch_scc1 L_novt
    s_or_b32 s23, s52, s56
    v_mov_b32 v1, s23
    s_lshl_b64 exec, 1, s21
    s_cmp_lg_u32 s49, 0
    s_cbranch_scc1 L_far1
    global_store_dword v70, v1, s[18:19]
L_back1:
    s_mov_b64 exec, -1
L_novt:
    s_waitcnt vmcnt(11)
    global_load_dwordx4 v[188:191], v5, s[6:7] offset:512 nt
    v_add_u32 v5, s39, v5
    s_lshl_b32 s23, s20, 2
    s_add_u32 s23, s23, s48
    s_lshl_b32 s23, s23, 2
    s_add_u32 s23, s23, s3
    s_lshl_b32 s23, s23, 15
    s_lshr_b32 s24, s21, 2
    s_lshl_b32 s24, s24, 7
    s_add_u32 s23, s23, s24
    s_lshl_b32 s24, s3, 12
    s_add_u32 m0, s24, 0x4000
    v_add_u32 v104, s23, v72
    v_lshrrev_b32 v1, 5, v0
    v_lshlrev_b32 v2, 3, v15
    v_lshl_add_u32 v2, v1, 7, v2
    v_and_b32 v1, 1, v8
    v_lshl_add_u32 v2, v1, 2, v2
    v_lshl_add_u32 v2, s3, 8, v2
    v_and_b32 v1, 16, v7
    v_mov_b32 v10, 0xffff
    v_lshlrev_b32 v10, v1, v10
    v_and_b32 v1, 2, v0
    v_cmp_eq_u32 vcc, 0, v1
    s_mov_b32 s27, 0x3e0293ee
    s_mov_b32 s26, 0
    v_cndmask_b32 v9, 0, v10, vcc
    v_sub_u32 v10, v10, v9
    s_lshl_b32 s23, s3, 2
    s_lshl_b64 s[0:1], 1, s23
    s_lshl_b32 s23, s22, 10
    s_lshl_b32 s24, s3, 8
    s_add_u32 s23, s23, s24
    s_add_u32 s23, s23, 0x40000
    v_lshl_add_u32 v106, v0, 2, s23
    v_mov_b32 v1, -1
    s_cmp_lg_u32 s49, 0
    s_cbranch_scc1 L_far2
    global_store_dword v106, v1, s[18:19]
L_back2:
    s_cmp_lg_u32 s3, 2
    s_cbranch_scc1 L_notouch
    v_mov_b32 v3, 0
    s_mov_b64 exec, 1
    global_load_dword v20, v6, s[8:9] nt
    global_load_dword v21, v104, s[12:13] nt
    global_load_dword v22, v3, s[14:15]
    s_mov_b64 exec, -1
L_notouch:
    s_waitcnt vmcnt(11)
    global_load_dwordx4 v[192:195], v5, s[6:7] offset:-4096 nt
    s_waitcnt vmcnt(11)
    global_load_dwordx4 v[196:199], v5, s[6:7] offset:0 nt
    s_waitcnt vmcnt(11)
    global_load_dwordx4 v[200:203], v5, s[6:7] offset:-3584 nt
    s_waitcnt vmcnt(11)
    global_load_dwordx4 v[204:207], v5, s[6:7] offset:512 nt
    v_add_u32 v5, s39, v5
    s_waitcnt vmcnt(11)
    global_load_dwordx4 v[208:211], v5, s[6:7] offset:-4096 nt
    s_waitcnt vmcnt(11)
    global_load_dwordx4 v[212:215], v5, s[6:7] offset:0 nt
    s_waitcnt vmcnt(11)
    global_load_dwordx4 v[216:219], v5, s[6:7] offset:-3584 nt
    s_waitcnt vmcnt(11)
    global_load_dwordx4 v[220:223], v5, s[6:7] offset:512 nt
    v_add_u32 v5, s39, v5
    s_waitcnt vmcnt(11)
    global_load_dwordx4 v[224:227], v5, s[6:7] offset:-4096 nt
    s_waitcnt vmcnt(11)
    global_load_dwordx4 v[228:231], v5, s[6:7] offset:0 nt
    s_waitcnt vmcnt(11)
    global_load_dwordx4 v[232:235], v5, s[6:7] offset:-3584 nt
    s_waitcnt vmcnt(11)
    global_load_dwordx4 v[236:239], v5, s[6:7] offset:512 nt
    v_add_u32 v5, s39, v5
    global_load_dwordx4 v[96:99], v68, s[18:19] sc1
    global_load_dwordx4 v[100:103], v69, s[18:19] sc1
    global_load_dword v44, v70, s[18:19] sc1
    s_waitcnt vmcnt(11)
    global_load_dwordx4 v[240:243], v5, s[6:7] offset:-4096 nt
    s_waitcnt vmcnt(11)
    global_load_dwordx4 v[244:247], v5, s[6:7] offset:0 nt
    s_waitcnt vmcnt(11)
    global_load_dwordx4 v[248:251], v5, s[6:7] offset:-3584 nt
    s_waitcnt vmcnt(11)
    global_load_dwordx4 v[252:255], v5, s[6:7] offset:512 nt
    s_waitcnt vmcnt(11)
    global_load_dwordx4 v[112:115], v6, s[8:9] offset:-4096 nt
    s_waitcnt vmcnt(11)
    global_load_dwordx4 v[116:119], v6, s[8:9] offset:0 nt
    s_waitcnt vmcnt(11)
    global_load_dwordx4 v[120:123], v6, s[8:9] offset:-3584 nt
    s_waitcnt vmcnt(11)
    global_load_dwordx4 v[124:127], v6, s[8:9] offset:512 nt
    v_add_u32 v6, s39, v6
    s_waitcnt vmcnt(11)
    global_load_dwordx4 v[48:51], v6, s[8:9] offset:-4096 nt
    s_waitcnt vmcnt(11)
    global_load_dwordx4 v[52:55], v6, s[8:9] offset:0 nt
    s_waitcnt vmcnt(11)
    global_load_dwordx4 v[56:59], v6, s[8:9] offset:-3584 nt
    s_waitcnt vmcnt(11)
L_qcheck:
    v_xor_b32 v96, s32, v96
    v_xor_b32 v97, s33, v97
    v_xor_b32 v98, s34, v98
    v_xor_b32 v99, s35, v99
    v_xor_b32 v100, s32, v100
    v_xor_b32 v101, s33, v101
    v_xor_b32 v102, s34, v102
    v_xor_b32 v103, s35, v103
    v_xor_b32 v44, s52, v44
    v_or3_b32 v40, v96, v97, v98
    v_or3_b32 v41, v99, v100, v101
    v_or3_b32 v40, v40, v102, v103
    v_or_b32 v40, v40, v41
    v_and_b32 v40, 0x3ff, v40
    v_and_or_b32 v40, v44, -2, v40
    v_cmp_ne_u32 vcc, 0, v40
    s_cbranch_vccnz L_slow_q
    v_cmp_ne_u32 vcc, 0, v44
    v_permlane32_swap_b32 v96, v100
    v_permlane32_swap_b32 v97, v101
    v_permlane32_swap_b32 v98, v102
    v_permlane32_swap_b32 v99, v103
    v_add_f32 v96, v96, v100
    v_add_f32 v97, v97, v101
    v_add_f32 v98, v98, v102
    v_add_f32 v99, v99, v103
    s_nop 0
    v_permlane16_swap_b32 v96, v98
    v_permlane16_swap_b32 v97, v99
    v_add_f32 v96, v96, v98
    v_add_f32 v97, v97, v99
    v_cvt_pk_bf16_f32 v96, v96, v97
    ds_write_b32 v2, v96 offset:36864
    s_and_b32 s23, vcc_lo, 0x55555555
    s_bcnt1_i32_b32 s23, s23
    s_and_b32 s24, vcc_lo, 0xaaaaaaaa
    s_bcnt1_i32_b32 s24, s24
    s_cmp_gt_u32 s24, s23
    s_cselect_b32 s57, 1, 0
    s_lshl_b32 s23, s48, 2
    s_add_u32 s23, s23, s3
    s_cmp_lg_u32 s23, 3
    s_cbranch_scc1 L_nodc
    s_lshl_b32 s23, s22, 7
    s_add_u32 s23, s23, 0x10000
    v_mov_b32 v1, s23
    v_mov_b32 v100, s57
    v_mov_b32 v102, s28
    v_mov_b32 v103, s29
    s_mov_b64 exec, 1
    global_store_dwordx4 v1, v[100:103], s[18:19] sc1
    s_mov_b64 exec, -1
L_nodc:
    global_load_dwordx4 v[60:63], v6, s[8:9] offset:512 nt
    v_add_u32 v6, s39, v6
    s_waitcnt lgkmcnt(0)
    s_barrier
    ds_read_b128 v[16:19], v14 offset:36864
    v_lshlrev_b32 v1, 6, v13
    s_lshl_b32 s23, s3, 4
    v_lshl_add_u32 v13, v8, 2, v1
    v_add_u32 v13, s23, v13
    s_waitcnt lgkmcnt(0)
    v_mov_b32 v14, v1
    s_cmp_lg_u32 s49, 0
    s_cbranch_scc1 L_second
L_second_done:
    v_mfma_f32_16x16x32_bf16 v[32:35], v[128:131], v[16:19], 0
    v_mfma_f32_16x16x32_bf16 v[36:39], v[132:135], v[16:19], 0
    v_mfma_f32_16x16x32_bf16 v[40:43], v[136:139], v[16:19], 0
    v_mfma_f32_16x16x32_bf16 v[44:47], v[140:143], v[16:19], 0
    s_waitcnt vmcnt(11)
    global_load_dwordx4 v[128:131], v6, s[8:9] offset:-4096 nt
    s_nop 2
    v_mov_b32_dpp v64, v32 quad_perm:[0,0,0,0] row_mask:0xf bank_mask:0xf
    v_mov_b32_dpp v65, v36 quad_perm:[0,0,0,0] row_mask:0xf bank_mask:0xf
    v_mov_b32_dpp v66, v40 quad_perm:[0,0,0,0] row_mask:0xf bank_mask:0xf
    v_mov_b32_dpp v67, v44 quad_perm:[0,0,0,0] row_mask:0xf bank_mask:0xf
    v_add_f32_dpp v64, v33, v64 quad_perm:[1,1,1,1] row_mask:0xf bank_mask:0xf
    v_add_f32_dpp v65, v37, v65 quad_perm:[1,1,1,1] row_mask:0xf bank_mask:0xf
    v_add_f32_dpp v66, v41, v66 quad_perm:[1,1,1,1] row_mask:0xf bank_mask:0xf
    v_add_f32_dpp v67, v45, v67 quad_perm:[1,1,1,1] row_mask:0xf bank_mask:0xf
    v_add_f32_dpp v64, v34, v64 quad_perm:[2,2,2,2] row_mask:0xf bank_mask:0xf
    v_add_f32_dpp v65, v38, v65 quad_perm:[2,2,2,2] row_mask:0xf bank_mask:0xf
    v_add_f32_dpp v66, v42, v66 quad_perm:[2,2,2,2] row_mask:0xf bank_mask:0xf
    v_add_f32_dpp v67, v46, v67 quad_perm:[2,2,2,2] row_mask:0xf bank_mask:0xf
    v_add_f32_dpp v64, v35, v64 quad_perm:[3,3,3,3] row_mask:0xf bank_mask:0xf
    v_add_f32_dpp v65, v39, v65 quad_perm:[3,3,3,3] row_mask:0xf bank_mask:0xf
    v_add_f32_dpp v66, v43, v66 quad_perm:[3,3,3,3] row_mask:0xf bank_mask:0xf
    v_add_f32_dpp v67, v47, v67 quad_perm:[3,3,3,3] row_mask:0xf bank_mask:0xf
    v_max3_f32 v11, v64, v65, v66
    v_max_f32 v11, v11, v67
    v_mfma_f32_16x16x32_bf16 v[32:35], v[144:147], v[16:19], 0
    v_mfma_f32_16x16x32_bf16 v[36:39], v[148:151], v[16:19], 0
    v_mfma_f32_16x16x32_bf16 v[40:43], v[152:155], v[16:19], 0
    v_mfma_f32_16x16x32_bf16 v[44:47], v[156:159], v[16:19], 0
    s_nop 4
    v_mov_b32_dpp v68, v32 quad_perm:[0,0,0,0] row_mask:0xf bank_mask:0xf
    v_mov_b32_dpp v69, v36 quad_perm:[0,0,0,0] row_mask:0xf bank_mask:0xf
    v_mov_b32_dpp v70, v40 quad_perm:[0,0,0,0] row_mask:0xf bank_mask:0xf
    v_mov_b32_dpp v71, v44 quad_perm:[0,0,0,0] row_mask:0xf bank_mask:0xf
    v_add_f32_dpp v68, v33, v68 quad_perm:[1,1,1,1] row_mask:0xf bank_mask:0xf
    v_add_f32_dpp v69, v37, v69 quad_perm:[1,1,1,1] row_mask:0xf bank_mask:0xf
    v_add_f32_dpp v70, v41, v70 quad_perm:[1,1,1,1] row_mask:0xf bank_mask:0xf
    v_add_f32_dpp v71, v45, v71 quad_perm:[1,1,1,1] row_mask:0xf bank_mask:0xf
    v_add_f32_dpp v68, v34, v68 quad_perm:[2,2,2,2] row_mask:0xf bank_mask:0xf
    v_add_f32_dpp v69, v38, v69 quad_perm:[2,2,2,2] row_mask:0xf bank_mask:0xf
    v_add_f32_dpp v70, v42, v70 quad_perm:[2,2,2,2] row_mask:0xf bank_mask:0xf
    v_add_f32_dpp v71, v46, v71 quad_perm:[2,2,2,2] row_mask:0xf bank_mask:0xf
    v_add_f32_dpp v68, v35, v68 quad_perm:[3,3,3,3] row_mask:0xf bank_mask:0xf
    v_add_f32_dpp v69, v39, v69 quad_perm:[3,3,3,3] row_mask:0xf bank_mask:0xf
    v_add_f32_dpp v70, v43, v70 quad_perm:[3,3,3,3] row_mask:0xf bank_mask:0xf
    v_add_f32_dpp v71, v47, v71 quad_perm:[3,3,3,3] row_mask:0xf bank_mask:0xf
    v_max3_f32 v11, v11, v68, v69
    v_max3_f32 v11, v11, v70, v71
    v_mfma_f32_16x16x32_bf16 v[32:35], v[160:163], v[16:19], 0
    v_mfma_f32_16x16x32_bf16 v[36:39], v[164:167], v[16:19], 0
    v_mfma_f32_16x16x32_bf16 v[40:43], v[168:171], v[16:19], 0
    v_mfma_f32_16x16x32_bf16 v[44:47], v[172:175], v[16:19], 0
    s_waitcnt vmcnt(11)
    global_load_dwordx4 v[132:135], v6, s[8:9] offset:0 nt
    s_nop 2
    v_mov_b32_dpp v72, v32 quad_perm:[0,0,0,0] row_mask:0xf bank_mask:0xf
    v_mov_b32_dpp v73, v36 quad_perm:[0,0,0,0] row_mask:0xf bank_mask:0xf
    v_mov_b32_dpp v74, v40 quad_perm:[0,0,0,0] row_mask:0xf bank_mask:0xf
    v_mov_b32_dpp v75, v44 quad_perm:[0,0,0,0] row_mask:0xf bank_mask:0xf
    v_add_f32_dpp v72, v33, v72 quad_perm:[1,1,1,1] row_mask:0xf bank_mask:0xf
    v_add_f32_dpp v73, v37, v73 quad_perm:[1,1,1,1] row_mask:0xf bank_mask:0xf
    v_add_f32_dpp v74, v41, v74 quad_perm:[1,1,1,1] row_mask:0xf bank_mask:0xf
    v_add_f32_dpp v75, v45, v75 quad_perm:[1,1,1,1] row_mask:0xf bank_mask:0xf
    v_add_f32_dpp v72, v34, v72 quad_perm:[2,2,2,2] row_mask:0xf bank_mask:0xf
    v_add_f32_dpp v73, v38, v73 quad_perm:[2,2,2,2] row_mask:0xf bank_mask:0xf
    v_add_f32_dpp v74, v42, v74 quad_perm:[2,2,2,2] row_mask:0xf bank_mask:0xf
    v_add_f32_dpp v75, v46, v75 quad_perm:[2,2,2,2] row_mask:0xf bank_mask:0xf
    v_add_f32_dpp v72, v35, v72 quad_perm:[3,3,3,3] row_mask:0xf bank_mask:0xf
    v_add_f32_dpp v73, v39, v73 quad_perm:[3,3,3,3] row_mask:0xf bank_mask:0xf
    v_add_f32_dpp v74, v43, v74 quad_perm:[3,3,3,3] row_mask:0xf bank_mask:0xf
    v_add_f32_dpp v75, v47, v75 quad_perm:[3,3,3,3] row_mask:0xf bank_mask:0xf
    v_max3_f32 v11, v11, v72, v73
    v_max3_f32 v11, v11, v74, v75
    v_mfma_f32_16x16x32_bf16 v[32:35], v[176:179], v[16:19], 0
    v_mfma_f32_16x16x32_bf16 v[36:39], v[180:183], v[16:19], 0
    v_mfma_f32_16x16x32_bf16 v[40:43], v[184:187], v[16:19], 0
    v_mfma_f32_16x16x32_bf16 v[44:47], v[188:191], v[16:19], 0
    s_nop 4
    v_mov_b32_dpp v76, v32 quad_perm:[0,0,0,0] row_mask:0xf bank_mask:0xf
    v_mov_b32_dpp v77, v36 quad_perm:[0,0,0,0] row_mask:0xf bank_mask:0xf
    v_mov_b32_dpp v78, v40 quad_perm:[0,0,0,0] row_mask:0xf bank_mask:0xf
    v_mov_b32_dpp v79, v44 quad_perm:[0,0,0,0] row_mask:0xf bank_mask:0xf
    v_add_f32_dpp v76, v33, v76 quad_perm:[1,1,1,1] row_mask:0xf bank_mask:0xf
    v_add_f32_dpp v77, v37, v77 quad_perm:[1,1,1,1] row_mask:0xf bank_mask:0xf
    v_add_f32_dpp v78, v41, v78 quad_perm:[1,1,1,1] row_mask:0xf bank_mask:0xf
    v_add_f32_dpp v79, v45, v79 quad_perm:[1,1,1,1] row_mask:0xf bank_mask:0xf
    v_add_f32_dpp v76, v34, v76 quad_perm:[2,2,2,2] row_mask:0xf bank_mask:0xf
    v_add_f32_dpp v77, v38, v77 quad_perm:[2,2,2,2] row_mask:0xf bank_mask:0xf
    v_add_f32_dpp v78, v42, v78 quad_perm:[2,2,2,2] row_mask:0xf bank_mask:0xf
    v_add_f32_dpp v79, v46, v79 quad_perm:[2,2,2,2] row_mask:0xf bank_mask:0xf
    v_add_f32_dpp v76, v35, v76 quad_perm:[3,3,3,3] row_mask:0xf bank_mask:0xf
    v_add_f32_dpp v77, v39, v77 quad_perm:[3,3,3,3] row_mask:0xf bank_mask:0xf
    v_add_f32_dpp v78, v43, v78 quad_perm:[3,3,3,3] row_mask:0xf bank_mask:0xf
    v_add_f32_dpp v79, v47, v79 quad_perm:[3,3,3,3] row_mask:0xf bank_mask:0xf
    v_max3_f32 v11, v11, v76, v77
    v_max3_f32 v11, v11, v78, v79
    v_mfma_f32_16x16x32_bf16 v[32:35], v[192:195], v[16:19], 0
    v_mfma_f32_16x16x32_bf16 v[36:39], v[196:199], v[16:19], 0
    v_mfma_f32_16x16x32_bf16 v[40:43], v[200:203], v[16:19], 0
    v_mfma_f32_16x16x32_bf16 v[44:47], v[204:207], v[16:19], 0
    s_waitcnt vmcnt(11)
    global_load_dwordx4 v[136:139], v6, s[8:9] offset:-3584 nt
    s_nop 2
    v_mov_b32_dpp v80, v32 quad_perm:[0,0,0,0] row_mask:0xf bank_mask:0xf
    v_mov_b32_dpp v81, v36 quad_perm:[0,0,0,0] row_mask:0xf bank_mask:0xf
    v_mov_b32_dpp v82, v40 quad_perm:[0,0,0,0] row_mask:0xf bank_mask:0xf
    v_mov_b32_dpp v83, v44 quad_perm:[0,0,0,0] row_mask:0xf bank_mask:0xf
    v_add_f32_dpp v80, v33, v80 quad_perm:[1,1,1,1] row_mask:0xf bank_mask:0xf
    v_add_f32_dpp v81, v37, v81 quad_perm:[1,1,1,1] row_mask:0xf bank_mask:0xf
    v_add_f32_dpp v82, v41, v82 quad_perm:[1,1,1,1] row_mask:0xf bank_mask:0xf
    v_add_f32_dpp v83, v45, v83 quad_perm:[1,1,1,1] row_mask:0xf bank_mask:0xf
    v_add_f32_dpp v80, v34, v80 quad_perm:[2,2,2,2] row_mask:0xf bank_mask:0xf
    v_add_f32_dpp v81, v38, v81 quad_perm:[2,2,2,2] row_mask:0xf bank_mask:0xf
    v_add_f32_dpp v82, v42, v82 quad_perm:[2,2,2,2] row_mask:0xf bank_mask:0xf
    v_add_f32_dpp v83, v46, v83 quad_perm:[2,2,2,2] row_mask:0xf bank_mask:0xf
    v_add_f32_dpp v80, v35, v80 quad_perm:[3,3,3,3] row_mask:0xf bank_mask:0xf
    v_add_f32_dpp v81, v39, v81 quad_perm:[3,3,3,3] row_mask:0xf bank_mask:0xf
    v_add_f32_dpp v82, v43, v82 quad_perm:[3,3,3,3] row_mask:0xf bank_mask:0xf
    v_add_f32_dpp v83, v47, v83 quad_perm:[3,3,3,3] row_mask:0xf bank_mask:0xf
    v_max3_f32 v11, v11, v80, v81
    v_max3_f32 v11, v11, v82, v83
    v_mfma_f32_16x16x32_bf16 v[32:35], v[208:211], v[16:19], 0
    v_mfma_f32_16x16x32_bf16 v[36:39], v[212:215], v[16:19], 0
    v_mfma_f32_16x16x32_bf16 v[40:43], v[216:219], v[16:19], 0
    v_mfma_f32_16x16x32_bf16 v[44:47], v[220:223], v[16:19], 0
    s_nop 4
    v_mov_b32_dpp v84, v32 quad_perm:[0,0,0,0] row_mask:0xf bank_mask:0xf
    v_mov_b32_dpp v85, v36 quad_perm:[0,0,0,0] row_mask:0xf bank_mask:0xf
    v_mov_b32_dpp v86, v40 quad_perm:[0,0,0,0] row_mask:0xf bank_mask:0xf
    v_mov_b32_dpp v87, v44 quad_perm:[0,0,0,0] row_mask:0xf bank_mask:0xf
    v_add_f32_dpp v84, v33, v84 quad_perm:[1,1,1,1] row_mask:0xf bank_mask:0xf
    v_add_f32_dpp v85, v37, v85 quad_perm:[1,1,1,1] row_mask:0xf bank_mask:0xf
    v_add_f32_dpp v86, v41, v86 quad_perm:[1,1,1,1] row_mask:0xf bank_mask:0xf
    v_add_f32_dpp v87, v45, v87 quad_perm:[1,1,1,1] row_mask:0xf bank_mask:0xf
    v_add_f32_dpp v84, v34, v84 quad_perm:[2,2,2,2] row_mask:0xf bank_mask:0xf
    v_add_f32_dpp v85, v38, v85 quad_perm:[2,2,2,2] row_mask:0xf bank_mask:0xf
    v_add_f32_dpp v86, v42, v86 quad_perm:[2,2,2,2] row_mask:0xf bank_mask:0xf
    v_add_f32_dpp v87, v46, v87 quad_perm:[2,2,2,2] row_mask:0xf bank_mask:0xf
    v_add_f32_dpp v84, v35, v84 quad_perm:[3,3,3,3] row_mask:0xf bank_mask:0xf
    v_add_f32_dpp v85, v39, v85 quad_perm:[3,3,3,3] row_mask:0xf bank_mask:0xf
    v_add_f32_dpp v86, v43, v86 quad_perm:[3,3,3,3] row_mask:0xf bank_mask:0xf
    v_add_f32_dpp v87, v47, v87 quad_perm:[3,3,3,3] row_mask:0xf bank_mask:0xf
    v_max3_f32 v11, v11, v84, v85
    v_max3_f32 v11, v11, v86, v87
    v_mfma_f32_16x16x32_bf16 v[32:35], v[224:227], v[16:19], 0
    v_mfma_f32_16x16x32_bf16 v[36:39], v[228:231], v[16:19], 0
    v_mfma_f32_16x16x32_bf16 v[40:43], v[232:235], v[16:19], 0
    v_mfma_f32_16x16x32_bf16 v[44:47], v[236:239], v[16:19], 0
    s_waitcnt vmcnt(11)
    global_load_dwordx4 v[140:143], v6, s[8:9] offset:512 nt
    v_add_u32 v6, s39, v6
    s_nop 1
    v_mov_b32_dpp v88, v32 quad_perm:[0,0,0,0] row_mask:0xf bank_mask:0xf
    v_mov_b32_dpp v89, v36 quad_perm:[0,0,0,0] row_mask:0xf bank_mask:0xf
    v_mov_b32_dpp v90, v40 quad_perm:[0,0,0,0] row_mask:0xf bank_mask:0xf
    v_mov_b32_dpp v91, v44 quad_perm:[0,0,0,0] row_mask:0xf bank_mask:0xf
    v_add_f32_dpp v88, v33, v88 quad_perm:[1,1,1,1] row_mask:0xf bank_mask:0xf
    v_add_f32_dpp v89, v37, v89 quad_perm:[1,1,1,1] row_mask:0xf bank_mask:0xf
    v_add_f32_dpp v90, v41, v90 quad_perm:[1,1,1,1] row_mask:0xf bank_mask:0xf
    v_add_f32_dpp v91, v45, v91 quad_perm:[1,1,1,1] row_mask:0xf bank_mask:0xf
    v_add_f32_dpp v88, v34, v88 quad_perm:[2,2,2,2] row_mask:0xf bank_mask:0xf
    v_add_f32_dpp v89, v38, v89 quad_perm:[2,2,2,2] row_mask:0xf bank_mask:0xf
    v_add_f32_dpp v90, v42, v90 quad_perm:[2,2,2,2] row_mask:0xf bank_mask:0xf
    v_add_f32_dpp v91, v46, v91 quad_perm:[2,2,2,2] row_mask:0xf bank_mask:0xf
    v_add_f32_dpp v88, v35, v88 quad_perm:[3,3,3,3] row_mask:0xf bank_mask:0xf
    v_add_f32_dpp v89, v39, v89 quad_perm:[3,3,3,3] row_mask:0xf bank_mask:0xf
    v_add_f32_dpp v90, v43, v90 quad_perm:[3,3,3,3] row_mask:0xf bank_mask:0xf
    v_add_f32_dpp v91, v47, v91 quad_perm:[3,3,3,3] row_mask:0xf bank_mask:0xf
    v_max3_f32 v11, v11, v88, v89
    v_max3_f32 v11, v11, v90, v91
    v_mfma_f32_16x16x32_bf16 v[32:35], v[240:243], v[16:19], 0
    v_mfma_f32_16x16x32_bf16 v[36:39], v[244:247], v[16:19], 0
    v_mfma_f32_16x16x32_bf16 v[40:43], v[248:251], v[16:19], 0
    v_mfma_f32_16x16x32_bf16 v[44:47], v[252:255], v[16:19], 0
    s_nop 4
    v_mov_b32_dpp v92, v32 quad_perm:[0,0,0,0] row_mask:0xf bank_mask:0xf
    v_mov_b32_dpp v93, v36 quad_perm:[0,0,0,0] row_mask:0xf bank_mask:0xf
    v_mov_b32_dpp v94, v40 quad_perm:[0,0,0,0] row_mask:0xf bank_mask:0xf
    v_mov_b32_dpp v95, v44 quad_perm:[0,0,0,0] row_mask:0xf bank_mask:0xf
    v_add_f32_dpp v92, v33, v92 quad_perm:[1,1,1,1] row_mask:0xf bank_mask:0xf
    v_add_f32_dpp v93, v37, v93 quad_perm:[1,1,1,1] row_mask:0xf bank_mask:0xf
    v_add_f32_dpp v94, v41, v94 quad_perm:[1,1,1,1] row_mask:0xf bank_mask:0xf
    v_add_f32_dpp v95, v45, v95 quad_perm:[1,1,1,1] row_mask:0xf bank_mask:0xf
    v_add_f32_dpp v92, v34, v92 quad_perm:[2,2,2,2] row_mask:0xf bank_mask:0xf
    v_add_f32_dpp v93, v38, v93 quad_perm:[2,2,2,2] row_mask:0xf bank_mask:0xf
    v_add_f32_dpp v94, v42, v94 quad_perm:[2,2,2,2] row_mask:0xf bank_mask:0xf
    v_add_f32_dpp v95, v46, v95 quad_perm:[2,2,2,2] row_mask:0xf bank_mask:0xf
    v_add_f32_dpp v92, v35, v92 quad_perm:[3,3,3,3] row_mask:0xf bank_mask:0xf
    v_add_f32_dpp v93, v39, v93 quad_perm:[3,3,3,3] row_mask:0xf bank_mask:0xf
    v_add_f32_dpp v94, v43, v94 quad_perm:[3,3,3,3] row_mask:0xf bank_mask:0xf
    v_add_f32_dpp v95, v47, v95 quad_perm:[3,3,3,3] row_mask:0xf bank_mask:0xf
    v_max3_f32 v11, v11, v92, v93
    v_max3_f32 v11, v11, v94, v95
    ds_write_b32 v13, v11 offset:37888
    s_waitcnt lgkmcnt(0)
    s_barrier
    ds_read_b128 v[32:35], v14 offset:37888
    ds_read_b128 v[36:39], v14 offset:37904
    ds_read_b128 v[40:43], v14 offset:37920
    ds_read_b128 v[44:47], v14 offset:37936
    s_waitcnt vmcnt(11)
    global_load_dwordx4 v[144:147], v6, s[8:9] offset:-4096 nt
    s_waitcnt lgkmcnt(0)
    v_max3_f32 v32, v32, v33, v34
    v_max3_f32 v32, v32, v35, v36
    v_max3_f32 v32, v32, v37, v38
    v_max3_f32 v32, v32, v39, v40
    v_max3_f32 v32, v32, v41, v42
    v_max3_f32 v32, v32, v43, v44
    v_max3_f32 v32, v32, v45, v46
    v_max_f32 v32, v32, v47
    v_mul_f32 v11, s27, v32
    v_fma_f32 v64, v64, s27, -v11
    v_fma_f32 v65, v65, s27, -v11
    v_fma_f32 v66, v66, s27, -v11
    v_fma_f32 v67, v67, s27, -v11
    v_fma_f32 v68, v68, s27, -v11
    v_fma_f32 v69, v69, s27, -v11
    v_fma_f32 v70, v70, s27, -v11
    v_fma_f32 v71, v71, s27, -v11
    v_fma_f32 v72, v72, s27, -v11
    v_fma_f32 v73, v73, s27, -v11
    v_fma_f32 v74, v74, s27, -v11
    v_fma_f32 v75, v75, s27, -v11
    v_fma_f32 v76, v76, s27, -v11
    v_fma_f32 v77, v77, s27, -v11
    v_fma_f32 v78, v78, s27, -v11
    v_fma_f32 v79, v79, s27, -v11
    v_fma_f32 v80, v80, s27, -v11
    v_fma_f32 v81, v81, s27, -v11
    v_fma_f32 v82, v82, s27, -v11
    v_fma_f32 v83, v83, s27, -v11
    v_fma_f32 v84, v84, s27, -v11
    v_fma_f32 v85, v85, s27, -v11
    v_fma_f32 v86, v86, s27, -v11
    v_fma_f32 v87, v87, s27, -v11
    v_fma_f32 v88, v88, s27, -v11
    v_fma_f32 v89, v89, s27, -v11
    v_fma_f32 v90, v90, s27, -v11
    v_fma_f32 v91, v91, s27, -v11
    v_fma_f32 v92, v92, s27, -v11
    v_fma_f32 v93, v93, s27, -v11
    v_fma_f32 v94, v94, s27, -v11
    v_fma_f32 v95, v95, s27, -v11
    s_waitcnt vmcnt(11)
    global_load_dwordx4 v[148:151], v6, s[8:9] offset:0 nt
    v_exp_f32 v64, v64
    v_exp_f32 v65, v65
    v_exp_f32 v66, v66
    v_exp_f32 v67, v67
    v_exp_f32 v68, v68
    v_exp_f32 v69, v69
    v_exp_f32 v70, v70
    v_exp_f32 v71, v71
    v_exp_f32 v72, v72
    v_exp_f32 v73, v73
    v_exp_f32 v74, v74
    v_exp_f32 v75, v75
    v_exp_f32 v76, v76
    v_exp_f32 v77, v77
    v_exp_f32 v78, v78
    v_exp_f32 v79, v79
    v_exp_f32 v80, v80
    v_exp_f32 v81, v81
    v_exp_f32 v82, v82
    v_exp_f32 v83, v83
    v_exp_f32 v84, v84
    v_exp_f32 v85, v85
    v_exp_f32 v86, v86
    v_exp_f32 v87, v87
    v_exp_f32 v88, v88
    v_exp_f32 v89, v89
    v_exp_f32 v90, v90
    v_exp_f32 v91, v91
    v_exp_f32 v92, v92
    v_exp_f32 v93, v93
    v_exp_f32 v94, v94
    v_exp_f32 v95, v95
    s_waitcnt vmcnt(11)
    global_load_dwordx4 v[152:155], v6, s[8:9] offset:-3584 nt
    v_add_f32 v32, v64, v65
    v_add_f32 v33, v66, v67
    v_add_f32 v32, v32, v68
    v_add_f32 v33, v33, v69
    v_add_f32 v32, v32, v70
    v_add_f32 v33, v33, v71
    v_add_f32 v32, v32, v72
    v_add_f32 v33, v33, v73
    v_add_f32 v32, v32, v74
    v_add_f32 v33, v33, v75
    v_add_f32 v32, v32, v76
    v_add_f32 v33, v33, v77
    v_add_f32 v32, v32, v78
    v_add_f32 v33, v33, v79
    v_add_f32 v32, v32, v80
    v_add_f32 v33, v33, v81
    v_add_f32 v32, v32, v82
    v_add_f32 v33, v33, v83
    v_add_f32 v32, v32, v84
    v_add_f32 v33, v33, v85
    v_add_f32 v32, v32, v86
    v_add_f32 v33, v33, v87
    v_add_f32 v32, v32, v88
    v_add_f32 v33, v33, v89
    v_add_f32 v32, v32, v90
    v_add_f32 v33, v33, v91
    v_add_f32 v32, v32, v92
    v_add_f32 v33, v33, v93
    v_add_f32 v32, v32, v94
    v_add_f32 v33, v33, v95
    v_add_f32 v32, v32, v33
    ds_write_b32 v13, v32 offset:38144
    s_waitcnt vmcnt(11)
    global_load_dwordx4 v[156:159], v6, s[8:9] offset:512 nt
    v_add_u32 v6, s39, v6
    s_waitcnt lgkmcnt(0)
    s_barrier
    ds_read_b128 v[32:35], v14 offset:38144
    ds_read_b128 v[36:39], v14 offset:38160
    ds_read_b128 v[40:43], v14 offset:38176
    ds_read_b128 v[44:47], v14 offset:38192
    s_lshl_b32 s23, s22, 6
    s_add_u32 s23, s23, 0x8000
    v_lshl_add_u32 v1, v0, 2, s23
    s_waitcnt vmcnt(11)
    global_load_dwordx4 v[160:163], v6, s[8:9] offset:-4096 nt
    s_waitcnt lgkmcnt(0)
    v_pk_add_f32 v[32:33], v[32:33], v[40:41]
    v_pk_add_f32 v[34:35], v[34:35], v[42:43]
    v_pk_add_f32 v[36:37], v[36:37], v[44:45]
    v_pk_add_f32 v[38:39], v[38:39], v[46:47]
    v_pk_add_f32 v[32:33], v[32:33], v[36:37]
    v_pk_add_f32 v[34:35], v[34:35], v[38:39]
    v_pk_add_f32 v[32:33], v[32:33], v[34:35]
    v_mov_b32 v36, v11
    v_add_f32 v37, v32, v33
    v_mov_b32 v38, s28
    v_mov_b32 v39, s29
    s_mov_b64 exec, s[0:1]
    s_cmp_lg_u32 s49, 0
    s_cbranch_scc1 L_far3
    global_store_dwordx4 v1, v[36:39], s[18:19]
L_back3:
    s_mov_b64 exec, -1
    s_waitcnt vmcnt(11)
    global_load_dwordx4 v[164:167], v6, s[8:9] offset:0 nt
    v_cvt_pk_bf16_f32 v64, v64, v64
    v_and_b32 v20, v64, v9
    v_and_b32 v21, v64, v10
    s_nop 1
    v_mfma_f32_16x16x16_bf16 v[24:27], v[20:21], v[112:113], 0
    v_mfma_f32_16x16x16_bf16 v[28:31], v[20:21], v[114:115], 0
    v_cvt_pk_bf16_f32 v65, v65, v65
    v_and_b32 v22, v65, v9
    v_and_b32 v23, v65, v10
    s_nop 1
    v_mfma_f32_16x16x16_bf16 v[24:27], v[22:23], v[116:117], v[24:27]
    v_mfma_f32_16x16x16_bf16 v[28:31], v[22:23], v[118:119], v[28:31]
    v_cvt_pk_bf16_f32 v66, v66, v66
    v_and_b32 v20, v66, v9
    v_and_b32 v21, v66, v10
    s_nop 1
    v_mfma_f32_16x16x16_bf16 v[24:27], v[20:21], v[120:121], v[24:27]
    v_mfma_f32_16x16x16_bf16 v[28:31], v[20:21], v[122:123], v[28:31]
    s_waitcnt vmcnt(11)
    global_load_dwordx4 v[168:171], v6, s[8:9] offset:-3584 nt
    v_cvt_pk_bf16_f32 v67, v67, v67
    v_and_b32 v22, v67, v9
    v_and_b32 v23, v67, v10
    s_nop 1
    v_mfma_f32_16x16x16_bf16 v[24:27], v[22:23], v[124:125], v[24:27]
    v_mfma_f32_16x16x16_bf16 v[28:31], v[22:23], v[126:127], v[28:31]
    v_cvt_pk_bf16_f32 v68, v68, v68
    v_and_b32 v20, v68, v9
    v_and_b32 v21, v68, v10
    s_nop 1
    v_mfma_f32_16x16x16_bf16 v[24:27], v[20:21], v[48:49], v[24:27]
    v_mfma_f32_16x16x16_bf16 v[28:31], v[20:21], v[50:51], v[28:31]
    v_cvt_pk_bf16_f32 v69, v69, v69
    v_and_b32 v22, v69, v9
    v_and_b32 v23, v69, v10
    s_nop 1
    v_mfma_f32_16x16x16_bf16 v[24:27], v[22:23], v[52:53], v[24:27]
    v_mfma_f32_16x16x16_bf16 v[28:31], v[22:23], v[54:55], v[28:31]
    s_waitcnt vmcnt(11)
    global_load_dwordx4 v[172:175], v6, s[8:9] offset:512 nt
    v_add_u32 v6, s39, v6
    v_cvt_pk_bf16_f32 v70, v70, v70
    v_and_b32 v20, v70, v9
    v_and_b32 v21, v70, v10
    s_nop 1
    v_mfma_f32_16x16x16_bf16 v[24:27], v[20:21], v[56:57], v[24:27]
    v_mfma_f32_16x16x16_bf16 v[28:31], v[20:21], v[58:59], v[28:31]
    v_cvt_pk_bf16_f32 v71, v71, v71
    v_and_b32 v22, v71, v9
    v_and_b32 v23, v71, v10
    s_nop 1
    v_mfma_f32_16x16x16_bf16 v[24:27], v[22:23], v[60:61], v[24:27]
    v_mfma_f32_16x16x16_bf16 v[28:31], v[22:23], v[62:63], v[28:31]
    v_cvt_pk_bf16_f32 v72, v72, v72
    v_and_b32 v20, v72, v9
    v_and_b32 v21, v72, v10
    s_nop 1
    v_mfma_f32_16x16x16_bf16 v[24:27], v[20:21], v[128:129], v[24:27]
    v_mfma_f32_16x16x16_bf16 v[28:31], v[20:21], v[130:131], v[28:31]
    s_waitcnt vmcnt(11)
    global_load_dwordx4 v[176:179], v6, s[8:9] offset:-4096 nt
    v_cvt_pk_bf16_f32 v73, v73, v73
    v_and_b32 v22, v73, v9
    v_and_b32 v23, v73, v10
    s_nop 1
    v_mfma_f32_16x16x16_bf16 v[24:27], v[22:23], v[132:133], v[24:27]
    v_mfma_f32_16x16x16_bf16 v[28:31], v[22:23], v[134:135], v[28:31]
    s_lshl_b32 s23, s21, 16
    s_lshl_b32 s24, s20, 7
    s_add_u32 s23, s23, s24
    s_lshl_b32 s24, s57, 13
    s_add_u32 s23, s23, s24
    s_add_u32 s23, s23, 0x200000
    v_lshl_add_u32 v38, v8, 14, s23
    v_bfe_u32 v1, v0, 3, 1
    v_lshl_add_u32 v38, v1, 12, v38
    v_and_b32 v1, 0x70, v7
    v_add_u32 v38, v38, v1
    v_lshl_add_u32 v3, s3, 10, v38
    v_and_b32 v4, 7, v0
    v_lshl_add_u32 v1, s3, 3, v4
    v_lshl_add_u32 v1, s20, 5, v1
    v_and_b32 v2, 1, v0
    v_xor_b32 v2, s22, v2
    v_cmp_gt_u32 vcc, 32, v0
    s_lshl_b32 s23, s3, 4
    s_add_u32 s23, s23, 0x8000
    v_cndmask_b32 v1, v2, v1, vcc
    v_lshl_add_u32 v41, v1, 6, s23
    v_cmp_eq_u32 vcc, 1, v8
    s_and_b32 s23, s21, 28
    s_lshl_b32 s23, s23, 7
    s_add_u32 s23, s23, 0x10000
    v_lshl_add_u32 v1, v4, 12, s23
    v_cndmask_b32 v41, v41, v1, vcc
    s_and_b32 s23, s21, 28
    s_add_u32 s23, s23, s3
    s_and_b32 s24, s23, 7
    s_xor_b32 s24, s24, s20
    s_lshl_b32 s23, s23, 3
    s_add_u32 s23, s23, s24
    s_lshr_b32 s24, s23, 1
    s_lshl_b32 s24, s24, 14
    s_and_b32 s23, s23, 1
    s_lshl_b32 s23, s23, 2
    s_add_u32 s23, s23, s48
    s_lshl_b32 s23, s23, 10
    s_add_u32 s23, s23, s24
    s_add_u32 s23, s23, 0x200000
    v_add_u32 v107, s23, v7
    s_waitcnt vmcnt(11)
    global_load_dwordx4 v[180:183], v6, s[8:9] offset:0 nt
    v_cvt_pk_bf16_f32 v74, v74, v74
    v_and_b32 v20, v74, v9
    v_and_b32 v21, v74, v10
    s_nop 1
    v_mfma_f32_16x16x16_bf16 v[24:27], v[20:21], v[136:137], v[24:27]
    v_mfma_f32_16x16x16_bf16 v[28:31], v[20:21], v[138:139], v[28:31]
    v_mov_b32 v40, -2
    v_lshl_add_u32 v32, s3, 11, v7
    v_lshrrev_b32 v1, 2, v0
    v_lshlrev_b32 v33, 4, v1
    v_bfe_u32 v1, v0, 1, 1
    v_lshl_add_u32 v33, v1, 10, v33
    v_and_b32 v1, 1, v0
    v_lshl_add_u32 v33, v1, 3, v33
    v_lshl_add_u32 v33, s3, 8, v33
    s_lshl_b32 s23, s20, 15
    s_lshl_b32 s24, s3, 13
    s_add_u32 s23, s23, s24
    s_lshl_b32 s24, s48, 8
    s_add_u32 s23, s23, s24
    s_add_u32 s23, s23, 0x41000
    v_lshl_add_u32 v34, v8, 10, s23
    v_lshl_add_u32 v34, v15, 4, v34
    v_lshrrev_b32 v1, 5, v0
    v_lshl_add_u32 v1, s3, 2, v1
    v_xor_b32 v1, v1, v15
    v_lshlrev_b32 v1, 4, v1
    v_lshl_add_u32 v1, v8, 8, v1
    v_lshl_add_u32 v35, s3, 11, v1
    v_xor_b32 v36, 32, v35
    v_xor_b32 v1, v15, v8
    v_lshlrev_b32 v1, 4, v1
    v_lshl_add_u32 v42, v15, 9, v1
    v_xor_b32 v43, 64, v42
    v_xor_b32 v44, 128, v42
    v_xor_b32 v45, 192, v42
    s_waitcnt vmcnt(11)
    global_load_dwordx4 v[184:187], v6, s[8:9] offset:-3584 nt
    v_cvt_pk_bf16_f32 v75, v75, v75
    v_and_b32 v22, v75, v9
    v_and_b32 v23, v75, v10
    s_nop 1
    v_mfma_f32_16x16x16_bf16 v[24:27], v[22:23], v[140:141], v[24:27]
    v_mfma_f32_16x16x16_bf16 v[28:31], v[22:23], v[142:143], v[28:31]
    s_lshr_b32 s23, s20, 1
    s_lshl_b32 s23, s23, 12
    s_lshl_b32 s24, s21, 5
    s_add_u32 s23, s23, s24
    s_and_b32 s24, s20, 1
    s_lshl_b32 s24, s24, 4
    s_add_u32 s23, s23, s24
    v_and_b32 v1, 7, v0
    v_lshl_add_u32 v39, v1, 1, s23
    v_bfe_u32 v1, v0, 4, 1
    v_lshl_add_u32 v39, v1, 11, v39
    v_lshrrev_b32 v1, 5, v0
    v_lshl_add_u32 v39, v1, 10, v39
    s_mov_b32 s0, 0x00ff00ff
    s_mov_b32 s1, 0x00ff00ff
    s_waitcnt vmcnt(11)
    global_load_dwordx4 v[188:191], v6, s[8:9] offset:512 nt
    v_add_u32 v6, s39, v6
    v_cvt_pk_bf16_f32 v76, v76, v76
    v_and_b32 v20, v76, v9
    v_and_b32 v21, v76, v10
    s_nop 1
    v_mfma_f32_16x16x16_bf16 v[24:27], v[20:21], v[144:145], v[24:27]
    v_mfma_f32_16x16x16_bf16 v[28:31], v[20:21], v[146:147], v[28:31]
    s_waitcnt vmcnt(11)
    global_load_dwordx4 v[192:195], v6, s[8:9] offset:-4096 nt
    v_cvt_pk_bf16_f32 v77, v77, v77
    v_and_b32 v22, v77, v9
    v_and_b32 v23, v77, v10
    s_nop 1
    v_mfma_f32_16x16x16_bf16 v[24:27], v[22:23], v[148:149], v[24:27]
    v_mfma_f32_16x16x16_bf16 v[28:31], v[22:23], v[150:151], v[28:31]
    s_waitcnt vmcnt(11)
    global_load_dwordx4 v[196:199], v6, s[8:9] offset:0 nt
    v_cvt_pk_bf16_f32 v78, v78, v78
    v_and_b32 v20, v78, v9
    v_and_b32 v21, v78, v10
    s_nop 1
    v_mfma_f32_16x16x16_bf16 v[24:27], v[20:21], v[152:153], v[24:27]
    v_mfma_f32_16x16x16_bf16 v[28:31], v[20:21], v[154:155], v[28:31]
    s_waitcnt vmcnt(11)
    global_load_dwordx4 v[200:203], v6, s[8:9] offset:-3584 nt
    v_cvt_pk_bf16_f32 v79, v79, v79
    v_and_b32 v22, v79, v9
    v_and_b32 v23, v79, v10
    s_nop 1
    v_mfma_f32_16x16x16_bf16 v[24:27], v[22:23], v[156:157], v[24:27]
    v_mfma_f32_16x16x16_bf16 v[28:31], v[22:23], v[158:159], v[28:31]
    s_waitcnt vmcnt(11)
    global_load_dwordx4 v[204:207], v6, s[8:9] offset:512 nt
    v_add_u32 v6, s39, v6
    v_cvt_pk_bf16_f32 v80, v80, v80
    v_and_b32 v20, v80, v9
    v_and_b32 v21, v80, v10
    s_nop 1
    v_mfma_f32_16x16x16_bf16 v[24:27], v[20:21], v[160:161], v[24:27]
    v_mfma_f32_16x16x16_bf16 v[28:31], v[20:21], v[162:163], v[28:31]
    global_load_dwordx4 v[108:111], v41, s[18:19] sc1
    global_load_dword v3, v3, s[18:19] sc1
    s_waitcnt vmcnt(11)
    global_load_dwordx4 v[208:211], v6, s[8:9] offset:-4096 nt
    v_cvt_pk_bf16_f32 v81, v81, v81
    v_and_b32 v22, v81, v9
    v_and_b32 v23, v81, v10
    s_nop 1
    v_mfma_f32_16x16x16_bf16 v[24:27], v[22:23], v[164:165], v[24:27]
    v_mfma_f32_16x16x16_bf16 v[28:31], v[22:23], v[166:167], v[28:31]
    v_cvt_pk_bf16_f32 v82, v82, v82
    v_and_b32 v20, v82, v9
    v_and_b32 v21, v82, v10
    s_nop 1
    v_mfma_f32_16x16x16_bf16 v[24:27], v[20:21], v[168:169], v[24:27]
    v_mfma_f32_16x16x16_bf16 v[28:31], v[20:21], v[170:171], v[28:31]
    s_waitcnt vmcnt(11)
    global_load_dwordx4 v[212:215], v6, s[8:9] offset:0 nt
    v_cvt_pk_bf16_f32 v83, v83, v83
    v_and_b32 v22, v83, v9
    v_and_b32 v23, v83, v10
    s_nop 1
    v_mfma_f32_16x16x16_bf16 v[24:27], v[22:23], v[172:173], v[24:27]
    v_mfma_f32_16x16x16_bf16 v[28:31], v[22:23], v[174:175], v[28:31]
    s_waitcnt vmcnt(11)
    global_load_dwordx4 v[216:219], v6, s[8:9] offset:-3584 nt
    v_cvt_pk_bf16_f32 v84, v84, v84
    v_and_b32 v20, v84, v9
    v_and_b32 v21, v84, v10
    s_nop 1
    v_mfma_f32_16x16x16_bf16 v[24:27], v[20:21], v[176:177], v[24:27]
    v_mfma_f32_16x16x16_bf16 v[28:31], v[20:21], v[178:179], v[28:31]
    s_waitcnt vmcnt(11)
    global_load_dwordx4 v[220:223], v6, s[8:9] offset:512 nt
    v_cvt_pk_bf16_f32 v85, v85, v85
    v_and_b32 v22, v85, v9
    v_and_b32 v23, v85, v10
    s_nop 1
    v_mfma_f32_16x16x16_bf16 v[24:27], v[22:23], v[180:181], v[24:27]
    v_mfma_f32_16x16x16_bf16 v[28:31], v[22:23], v[182:183], v[28:31]
    v_cvt_pk_bf16_f32 v86, v86, v86
    v_and_b32 v20, v86, v9
    v_and_b32 v21, v86, v10
    s_waitcnt vmcnt(11)
    s_nop 0
    v_mfma_f32_16x16x16_bf16 v[24:27], v[20:21], v[184:185], v[24:27]
    v_mfma_f32_16x16x16_bf16 v[28:31], v[20:21], v[186:187], v[28:31]
    v_cvt_pk_bf16_f32 v87, v87, v87
    v_and_b32 v22, v87, v9
    v_and_b32 v23, v87, v10
    s_waitcnt vmcnt(10)
    s_nop 0
    v_mfma_f32_16x16x16_bf16 v[24:27], v[22:23], v[188:189], v[24:27]
    v_mfma_f32_16x16x16_bf16 v[28:31], v[22:23], v[190:191], v[28:31]
    v_cvt_pk_bf16_f32 v88, v88, v88
    v_and_b32 v20, v88, v9
    v_and_b32 v21, v88, v10
    s_waitcnt vmcnt(9)
    s_nop 0
    v_mfma_f32_16x16x16_bf16 v[24:27], v[20:21], v[192:193], v[24:27]
    v_mfma_f32_16x16x16_bf16 v[28:31], v[20:21], v[194:195], v[28:31]
    v_cvt_pk_bf16_f32 v89, v89, v89
    v_and_b32 v22, v89, v9
    v_and_b32 v23, v89, v10
    s_waitcnt vmcnt(8)
    s_nop 0
    v_mfma_f32_16x16x16_bf16 v[24:27], v[22:23], v[196:197], v[24:27]
    v_mfma_f32_16x16x16_bf16 v[28:31], v[22:23], v[198:199], v[28:31]
    v_cvt_pk_bf16_f32 v90, v90, v90
    v_and_b32 v20, v90, v9
    v_and_b32 v21, v90, v10
    s_waitcnt vmcnt(7)
    s_nop 0
    v_mfma_f32_16x16x16_bf16 v[24:27], v[20:21], v[200:201], v[24:27]
    v_mfma_f32_16x16x16_bf16 v[28:31], v[20:21], v[202:203], v[28:31]
    v_cvt_pk_bf16_f32 v91, v91, v91
    v_and_b32 v22, v91, v9
    v_and_b32 v23, v91, v10
    s_waitcnt vmcnt(6)
    s_nop 0
    v_mfma_f32_16x16x16_bf16 v[24:27], v[22:23], v[204:205], v[24:27]
    v_mfma_f32_16x16x16_bf16 v[28:31], v[22:23], v[206:207], v[28:31]
    v_cvt_pk_bf16_f32 v92, v92, v92
    v_and_b32 v20, v92, v9
    v_and_b32 v21, v92, v10
    s_waitcnt vmcnt(3)
    s_nop 0
    v_mfma_f32_16x16x16_bf16 v[24:27], v[20:21], v[208:209], v[24:27]
    v_mfma_f32_16x16x16_bf16 v[28:31], v[20:21], v[210:211], v[28:31]
    v_readlane_b32 s23, v108, 32
    v_readlane_b32 s24, v108, 33
    v_readlane_b32 s25, v109, 33
    v_readlane_b32 s30, v109, 32
    v_mov_b32 v46, s24
    v_subrev_f32 v46, s23, v46
    v_exp_f32 v46, v46
    v_xor_b32 v110, s28, v110
    v_xor_b32 v111, s29, v111
    v_cmp_eq_u32 vcc, 1, v108
    v_or_b32 v110, v110, v111
    v_cmp_ne_u32 s[36:37], 0, v110
    v_lshrrev_b32 v1, 3, v0
    s_lshr_b32 s23, vcc_lo, 16
    v_bfe_u32 v1, s23, v1, 1
    v_lshl_add_u32 v37, v1, 13, v107
    v_mul_f32 v46, s25, v46
    v_add_f32 v46, s30, v46
    v_rcp_f32 v46, v46
    s_nop 0
    v_mov_b32 v47, v46
    v_cvt_pk_bf16_f32 v93, v93, v93
    v_and_b32 v22, v93, v9
    v_and_b32 v23, v93, v10
    s_waitcnt vmcnt(2)
    s_nop 0
    v_mfma_f32_16x16x16_bf16 v[24:27], v[22:23], v[212:213], v[24:27]
    v_mfma_f32_16x16x16_bf16 v[28:31], v[22:23], v[214:215], v[28:31]
    global_load_lds_dwordx4 v104, s[12:13] offset:0 nt
    v_add_u32 v104, 0x1c00, v104
    v_xor_b32 v104, 64, v104
    global_load_lds_dwordx4 v104, s[12:13] offset:1024 nt
    v_add_u32 v104, 0x1c00, v104
    v_xor_b32 v104, 64, v104
    global_load_lds_dwordx4 v104, s[12:13] offset:2048 nt
    v_add_u32 v104, 0x1c00, v104
    v_xor_b32 v104, 64, v104
    global_load_lds_dwordx4 v104, s[12:13] offset:3072 nt
    v_cvt_pk_bf16_f32 v94, v94, v94
    v_and_b32 v20, v94, v9
    v_and_b32 v21, v94, v10
    s_waitcnt vmcnt(5)
    s_nop 0
    v_mfma_f32_16x16x16_bf16 v[24:27], v[20:21], v[216:217], v[24:27]
    v_mfma_f32_16x16x16_bf16 v[28:31], v[20:21], v[218:219], v[28:31]
    v_cvt_pk_bf16_f32 v95, v95, v95
    v_and_b32 v22, v95, v9
    v_and_b32 v23, v95, v10
    s_waitcnt vmcnt(4)
    s_nop 0
    v_mfma_f32_16x16x16_bf16 v[24:27], v[22:23], v[220:221], v[24:27]
    v_mfma_f32_16x16x16_bf16 v[28:31], v[22:23], v[222:223], v[28:31]
    s_cmp_lg_u32 s37, 0
    s_cbranch_scc1 L_slow_ml
L_ml_ok:
    s_nop 4
    ds_write_b128 v32, v[24:27] offset:0
    ds_write_b128 v32, v[28:31] offset:1024
    s_waitcnt lgkmcnt(0)
    s_barrier
    ds_read_b64 v[96:97], v33 offset:0
    ds_read_b64 v[98:99], v33 offset:2048
    ds_read_b64 v[100:101], v33 offset:4096
    ds_read_b64 v[102:103], v33 offset:6144
    s_waitcnt lgkmcnt(2)
    v_pk_add_f32 v[96:97], v[96:97], v[98:99]
    s_waitcnt lgkmcnt(0)
    v_pk_add_f32 v[100:101], v[100:101], v[102:103]
    v_pk_add_f32 v[96:97], v[96:97], v[100:101]
    v_pk_mul_f32 v[96:97], v[96:97], v[46:47]
    v_cvt_pk_bf16_f32 v2, v96, v97
    v_min_u32 v2, v2, v40
    s_cmp_lg_u32 s49, 0
    s_cbranch_scc1 L_far4
    global_store_dword v106, v2, s[18:19]
L_back4:
    s_barrier
    s_cmp_lg_u32 s36, 0
    s_cbranch_scc1 L_slow_cert
L_poll1:
    global_load_dwordx4 v[96:99], v34, s[18:19] offset:-4096 sc1
    global_load_dwordx4 v[100:103], v34, s[18:19] sc1
    s_add_u32 s26, s26, 1
    s_cmp_gt_u32 s26, 400000
    s_cbranch_scc1 L_end
    s_waitcnt vmcnt(1)
    ds_write_b128 v35, v[96:99] offset:8192
    v_max3_u32 v3, v96, v97, v98
    v_max_u32 v3, v3, v99
    s_waitcnt vmcnt(0)
    ds_write_b128 v36, v[100:103] offset:9216
    v_max3_u32 v3, v3, v100, v101
    v_max3_u32 v3, v3, v102, v103
    v_cmp_eq_u32 vcc, -1, v3
    s_waitcnt lgkmcnt(0)
    s_and_b64 exec, exec, vcc
    s_cbranch_scc1 L_poll1
    s_mov_b64 exec, -1
    s_barrier
    ds_read_b64_tr_b16 v[48:49], v12 offset:16384
    ds_read_b64_tr_b16 v[50:51], v12 offset:16896
    ds_read_b128 v[160:163], v42 offset:8192
    ds_read_b128 v[164:167], v42 offset:8448
    ds_read_b64_tr_b16 v[52:53], v12 offset:20480
    ds_read_b64_tr_b16 v[54:55], v12 offset:20992
    ds_read_b128 v[168:171], v43 offset:8192
    ds_read_b128 v[172:175], v43 offset:8448
    ds_read_b64_tr_b16 v[56:57], v12 offset:24576
    ds_read_b64_tr_b16 v[58:59], v12 offset:25088
    ds_read_b128 v[176:179], v44 offset:8192
    ds_read_b128 v[180:183], v44 offset:8448
    s_waitcnt lgkmcnt(9)
    v_mfma_f32_16x16x32_bf16 v[24:27], v[160:163], v[48:51], 0
    s_waitcnt lgkmcnt(8)
    v_mfma_f32_16x16x32_bf16 v[24:27], v[164:167], v[48:51], v[24:27]
    ds_read_b64_tr_b16 v[60:61], v12 offset:28672
    ds_read_b64_tr_b16 v[62:63], v12 offset:29184
    ds_read_b128 v[184:187], v45 offset:8192
    ds_read_b128 v[188:191], v45 offset:8448
    s_waitcnt lgkmcnt(9)
    v_mfma_f32_16x16x32_bf16 v[24:27], v[168:171], v[52:55], v[24:27]
    s_waitcnt lgkmcnt(8)
    v_mfma_f32_16x16x32_bf16 v[24:27], v[172:175], v[52:55], v[24:27]
    s_waitcnt lgkmcnt(5)
    v_mfma_f32_16x16x32_bf16 v[24:27], v[176:179], v[56:59], v[24:27]
    s_waitcnt lgkmcnt(4)
    v_mfma_f32_16x16x32_bf16 v[24:27], v[180:183], v[56:59], v[24:27]
    s_waitcnt lgkmcnt(1)
    v_mfma_f32_16x16x32_bf16 v[24:27], v[184:187], v[60:63], v[24:27]
    s_waitcnt lgkmcnt(0)
    v_mfma_f32_16x16x32_bf16 v[24:27], v[188:191], v[60:63], v[24:27]
    s_cmp_lg_u32 s3, 0
    s_nop 6
    v_and_or_b32 v24, v24, v105, s32
    v_and_or_b32 v25, v25, v105, s33
    v_and_or_b32 v26, v26, v105, s34
    v_and_or_b32 v27, v27, v105, s35
    global_store_dwordx4 v37, v[24:27], s[18:19] sc1
    s_barrier
    s_cbranch_scc1 L_fin
    global_load_dwordx4 v[192:195], v38, s[18:19] offset:0 sc1
    global_load_dwordx4 v[196:199], v38, s[18:19] offset:1024 sc1
    global_load_dwordx4 v[200:203], v38, s[18:19] offset:2048 sc1
    global_load_dwordx4 v[204:207], v38, s[18:19] offset:3072 sc1
    s_waitcnt vmcnt(4)
L_poll2:
    s_add_u32 s26, s26, 1
    s_cmp_gt_u32 s26, 400000
    s_cbranch_scc1 L_end
    global_load_dwordx4 v[208:211], v38, s[18:19] offset:0 sc1
    global_load_dwordx4 v[212:215], v38, s[18:19] offset:1024 sc1
    global_load_dwordx4 v[216:219], v38, s[18:19] offset:2048 sc1
    global_load_dwordx4 v[220:223], v38, s[18:19] offset:3072 sc1
    s_waitcnt vmcnt(7)
    v_xor_b32 v112, s32, v192
    v_xor_b32 v113, s33, v193
    v_xor_b32 v114, s34, v194
    v_xor_b32 v115, s35, v195
    v_or3_b32 v3, v112, v113, v114
    v_or_b32 v3, v3, v115
    s_waitcnt vmcnt(6)
    v_xor_b32 v116, s32, v196
    v_xor_b32 v117, s33, v197
    v_xor_b32 v118, s34, v198
    v_xor_b32 v119, s35, v199
    v_or3_b32 v3, v3, v116, v117
    v_or3_b32 v3, v3, v118, v119
    v_pk_add_f32 v[28:29], v[112:113], v[116:117]
    v_pk_add_f32 v[30:31], v[114:115], v[118:119]
    s_waitcnt vmcnt(5)
    v_xor_b32 v120, s32, v200
    v_xor_b32 v121, s33, v201
    v_xor_b32 v122, s34, v202
    v_xor_b32 v123, s35, v203
    v_or3_b32 v3, v3, v120, v121
    v_or3_b32 v3, v3, v122, v123
    v_pk_add_f32 v[28:29], v[28:29], v[120:121]
    v_pk_add_f32 v[30:31], v[30:31], v[122:123]
    s_waitcnt vmcnt(4)
    v_xor_b32 v124, s32, v204
    v_xor_b32 v125, s33, v205
    v_xor_b32 v126, s34, v206
    v_xor_b32 v127, s35, v207
    v_or3_b32 v3, v3, v124, v125
    v_or3_b32 v3, v3, v126, v127
    v_and_b32 v3, 0x3ff, v3
    v_cmp_ne_u32 vcc, 0, v3
    v_pk_add_f32 v[28:29], v[28:29], v[124:125]
    v_pk_add_f32 v[30:31], v[30:31], v[126:127]
    s_and_b64 exec, exec, vcc
    s_cbranch_scc0 L_poll2_done
    global_load_dwordx4 v[192:195], v38, s[18:19] offset:0 sc1
    global_load_dwordx4 v[196:199], v38, s[18:19] offset:1024 sc1
    global_load_dwordx4 v[200:203], v38, s[18:19] offset:2048 sc1
    global_load_dwordx4 v[204:207], v38, s[18:19] offset:3072 sc1
    s_waitcnt vmcnt(7)
    v_xor_b32 v112, s32, v208
    v_xor_b32 v113, s33, v209
    v_xor_b32 v114, s34, v210
    v_xor_b32 v115, s35, v211
    v_or3_b32 v3, v112, v113, v114
    v_or_b32 v3, v3, v115
    s_waitcnt vmcnt(6)
    v_xor_b32 v116, s32, v212
    v_xor_b32 v117, s33, v213
    v_xor_b32 v118, s34, v214
    v_xor_b32 v119, s35, v215
    v_or3_b32 v3, v3, v116, v117
    v_or3_b32 v3, v3, v118, v119
    v_pk_add_f32 v[28:29], v[112:113], v[116:117]
    v_pk_add_f32 v[30:31], v[114:115], v[118:119]
    s_waitcnt vmcnt(5)
    v_xor_b32 v120, s32, v216
    v_xor_b32 v121, s33, v217
    v_xor_b32 v122, s34, v218
    v_xor_b32 v123, s35, v219
    v_or3_b32 v3, v3, v120, v121
    v_or3_b32 v3, v3, v122, v123
    v_pk_add_f32 v[28:29], v[28:29], v[120:121]
    v_pk_add_f32 v[30:31], v[30:31], v[122:123]
    s_waitcnt vmcnt(4)
    v_xor_b32 v124, s32, v220
    v_xor_b32 v125, s33, v221
    v_xor_b32 v126, s34, v222
    v_xor_b32 v127, s35, v223
    v_or3_b32 v3, v3, v124, v125
    v_or3_b32 v3, v3, v126, v127
    v_and_b32 v3, 0x3ff, v3
    v_cmp_ne_u32 vcc, 0, v3
    v_pk_add_f32 v[28:29], v[28:29], v[124:125]
    v_pk_add_f32 v[30:31], v[30:31], v[126:127]
    s_and_b64 exec, exec, vcc
    s_cbranch_scc1 L_poll2
L_poll2_done:
    s_mov_b64 exec, -1
    v_permlane32_swap_b32 v28, v29
    v_permlane32_swap_b32 v30, v31
    v_add_f32 v28, v28, v29
    v_add_f32 v30, v30, v31
    s_nop 1
    v_permlane16_swap_b32 v28, v30
    v_add_f32 v28, v28, v30
    s_cmp_lg_u32 s2, 0
    s_nop 0
    v_add_f32_dpp v28, v28, v28 row_ror:8 row_mask:0xf bank_mask:0xf
    s_mov_b64 exec, s[0:1]
    v_cvt_pk_bf16_f32 v28, v28, v28
    global_store_short v39, v28, s[14:15]
    s_cbranch_scc1 L_noepoch
    s_mov_b64 exec, 1
    v_mov_b32 v116, s28
    v_mov_b32 v117, s29
    v_mov_b32 v118, 0
    global_store_dwordx2 v118, v[116:117], s[18:19]
L_noepoch:
L_fin:
L_end:
    s_endpgm
L_far0:
    global_store_dwordx4 v4, v[32:35], s[18:19] sc1
    s_branch L_back0
L_far1:
    global_store_dword v70, v1, s[18:19] sc1
    s_branch L_back1
L_far2:
    global_store_dword v106, v1, s[18:19] sc1
    s_branch L_back2
L_far3:
    global_store_dwordx4 v1, v[36:39], s[18:19] sc1
    s_branch L_back3
L_far4:
    global_store_dword v106, v2, s[18:19] sc1
    s_branch L_back4
L_second:
    v_and_b32 v32, 7, v0
    s_lshl_b32 s23, s20, 5
    v_lshl_add_u32 v32, v32, 2, s23
    global_load_dword v32, v32, s[16:17] sc1
    s_waitcnt vmcnt(0)
    v_cmp_ne_u32 vcc, s50, v32
    s_nop 1
    s_or_b32 s49, vcc_lo, vcc_hi
    s_branch L_second_done
L_slow_q:
    global_load_dwordx4 v[96:99], v68, s[18:19] sc1
    global_load_dwordx4 v[100:103], v69, s[18:19] sc1
    global_load_dword v44, v70, s[18:19] sc1
    s_add_u32 s26, s26, 1
    s_cmp_gt_u32 s26, 400000
    s_cbranch_scc1 L_end
    s_waitcnt vmcnt(0)
    s_branch L_qcheck
L_slow_ml:
    global_load_dwordx4 v[108:111], v41, s[18:19] sc1
    s_add_u32 s26, s26, 1
    s_cmp_gt_u32 s26, 400000
    s_cbranch_scc1 L_end
    s_waitcnt vmcnt(0)
    v_readlane_b32 s23, v108, 32
    v_readlane_b32 s24, v108, 33
    v_readlane_b32 s25, v109, 33
    v_readlane_b32 s30, v109, 32
    v_mov_b32 v46, s24
    v_subrev_f32 v46, s23, v46
    v_exp_f32 v46, v46
    v_xor_b32 v110, s28, v110
    v_xor_b32 v111, s29, v111
    v_cmp_eq_u32 vcc, 1, v108
    v_or_b32 v110, v110, v111
    v_cmp_ne_u32 s[36:37], 0, v110
    v_lshrrev_b32 v1, 3, v0
    s_lshr_b32 s23, vcc_lo, 16
    v_bfe_u32 v1, s23, v1, 1
    v_lshl_add_u32 v37, v1, 13, v107
    v_mul_f32 v46, s25, v46
    v_add_f32 v46, s30, v46
    v_rcp_f32 v46, v46
    s_nop 0
    v_mov_b32 v47, v46
    s_cmp_lg_u32 s37, 0
    s_cbranch_scc1 L_slow_ml
    s_branch L_ml_ok
L_slow_cert:
    global_load_dwordx4 v[108:111], v41, s[18:19] sc1
    s_add_u32 s26, s26, 1
    s_cmp_gt_u32 s26, 400000
    s_cbranch_scc1 L_end
    s_waitcnt vmcnt(0)
    v_xor_b32 v110, s28, v110
    v_xor_b32 v111, s29, v111
    v_cmp_eq_u32 vcc, 1, v108
    v_or_b32 v110, v110, v111
    v_cmp_ne_u32 s[36:37], 0, v110
    v_lshrrev_b32 v1, 3, v0
    s_lshr_b32 s23, vcc_lo, 16
    v_bfe_u32 v1, s23, v1, 1
    v_lshl_add_u32 v37, v1, 13, v107
    s_nop 1
    s_cmp_lg_u32 s36, 0
    s_cbranch_scc1 L_slow_cert
    s_branch L_poll1
    .fill 512, 4, 0xbf810000
.section .rodata,"a"
.p2align 6
.amdhsa_kernel standalone__sliding_block_cached__sampling_kernel
  .amdhsa_next_free_vgpr 256
  .amdhsa_next_free_sgpr 58
  .amdhsa_accum_offset 256
  .amdhsa_group_segment_fixed_size 0
  .amdhsa_kernarg_size 64
  .amdhsa_user_sgpr_count 2
  .amdhsa_user_sgpr_kernarg_segment_ptr 1
  .amdhsa_system_sgpr_workgroup_id_x 1
  .amdhsa_float_denorm_mode_32 3
.end_amdhsa_kernel
```
